```python
import torch

def _softmax(x, axis=-1):
    return torch.softmax(x, dim=axis)
def _gelu(x):
    return torch.nn.functional.gelu(x, approximate="tanh")
def _silu(x):
    return torch.nn.functional.silu(x)
def _sigmoid(x):
    return torch.sigmoid(x)
def _layernorm(x, axis=-1, eps=1e-5):
    m = x.mean(dim=axis, keepdim=True)
    v = x.var(dim=axis, keepdim=True, unbiased=False)
    return (x - m) / torch.sqrt(v + eps)
def _scatter_add(tgt, idx, src, axis=0):
    return tgt.clone().index_add_(axis, idx, src)
def _segment_sum(src, seg, n):
    out = torch.zeros((n,) + src.shape[1:], dtype=src.dtype)
    return out.index_add_(0, seg, src)
def _pad(x, pw):
    flat = tuple(v for pair in reversed(pw) for v in pair)
    return torch.nn.functional.pad(x, flat)

kernel_name = 'standalone__qk_norm__prompt'

def setup_inputs():

    _w = (lambda a: (lambda t: t.to(torch.bfloat16) if t.is_floating_point() else t)(torch.as_tensor(a)))
    B, H, S, D = 4, 16, 2048, 448
    Dh = D // H
    return {
        "q": _w((lambda *s: torch.randn(*s, dtype=torch.bfloat16) * 0.05)(B, H, S, Dh)),
        "k": _w((lambda *s: torch.randn(*s, dtype=torch.bfloat16) * 0.05)(B, H, S, Dh)),
        "v": _w((lambda *s: torch.randn(*s, dtype=torch.bfloat16) * 0.8)(B, H, S, Dh)),
        "t": _w(torch.abs((lambda *s: torch.randn(*s, dtype=torch.bfloat16) * 0.8)(H)) + 1.0),
    }

def reference(q, k, v, t):
    eps = 1e-6
    qn = q / (torch.sqrt((q * q).sum(axis=-1, keepdims=True)) + eps)
    kn = k / (torch.sqrt((k * k).sum(axis=-1, keepdims=True)) + eps)
    logits = torch.einsum('bhqd,bhkd->bhqk', qn, kn) * t[None, :, None, None]
    attn = _softmax(logits, axis=-1)
    return torch.einsum('bhqk,bhkd->bhqd', attn, v)
```

```asm
; @launch grid=(256,1,1) block=(512,1,1) lds=110592
.amdgcn_target "amdgcn-amd-amdhsa--gfx950"
.text
.globl standalone__qk_norm__prompt_kernel
.p2align 8
.type standalone__qk_norm__prompt_kernel,@function
standalone__qk_norm__prompt_kernel:
    s_cmp_ge_u32 s2, 256
    s_cbranch_scc1 L_exit
    s_load_dwordx8 s[4:11], s[0:1], 0
    s_load_dwordx2 s[12:13], s[0:1], 32
    v_and_b32 v1, 63, v0
    v_lshrrev_b32 v13, 6, v0
    v_and_b32 v12, 31, v1
    v_readfirstlane_b32 s33, v13
    s_and_b32 s40, s2, 7
    s_lshr_b32 s41, s2, 5
    s_lshl_b32 s41, s41, 3
    s_or_b32 s40, s40, s41
    s_mul_i32 s32, s40, 114688
    s_and_b32 s40, s40, 15
    s_lshr_b32 s41, s40, 1
    s_lshl_b32 s41, s41, 2
    s_and_b32 s42, s40, 1
    v_lshrrev_b32 v13, 5, v1
    v_mul_u32_u24 v7, 56, v12
    v_lshl_add_u32 v17, v13, 3, v7
    v_mul_u32_u24 v14, 28, v13
    v_add_u32 v7, v7, v14
    v_lshlrev_b32 v5, 4, v1
    s_mul_i32 s35, s33, 1792
    s_add_u32 s34, s32, s35
    s_lshr_b32 s35, s2, 3
    s_and_b32 s35, s35, 3
    s_mul_i32 s35, s35, 28672
    s_mul_i32 s36, s33, 3584
    s_add_u32 s39, s32, s35
    s_add_u32 s39, s39, s36
    s_mov_b32 s22, 7340032
    s_mov_b32 s23, 0x00020000
    s_mov_b32 s26, 7340032
    s_mov_b32 s27, 0x00020000
    s_mov_b32 s18, 7340032
    s_mov_b32 s19, 0x00020000
    s_mov_b32 s30, 7340032
    s_mov_b32 s31, 0x00020000
    s_mul_i32 s49, s33, 2560
    s_add_u32 s49, s49, 16384
    s_waitcnt lgkmcnt(0)
    s_mov_b32 s20, s6
    s_and_b32 s21, s7, 0xffff
    s_mov_b32 s24, s8
    s_and_b32 s25, s9, 0xffff
    s_mov_b32 s16, s4
    s_and_b32 s17, s5, 0xffff
    s_mov_b32 s28, s12
    s_and_b32 s29, s13, 0xffff
    s_load_dword s38, s[10:11], s41
    buffer_load_dwordx4 v[82:85], v7, s[20:23], s34 offen
    buffer_load_dwordx3 v[86:88], v7, s[20:23], s34 offen offset:16
    buffer_load_dwordx4 v[98:101], v7, s[16:19], s39 offen
    buffer_load_dwordx3 v[102:104], v7, s[16:19], s39 offen offset:16
    s_mov_b32 m0, s49
    s_nop 0
    buffer_load_dwordx4 v5, s[24:27], s34 offen lds
    s_add_u32 m0, s49, 384
    s_nop 0
    buffer_load_dwordx4 v5, s[24:27], s34 offen offset:896 lds
    v_mov_b32 v9, 0xdddddddd
    v_mov_b32 v2, v5
    s_lshl_b32 s40, s33, 11
    v_add_u32 v6, s40, v5
    v_lshrrev_b32 v12, 5, v1
    v_bfe_u32 v13, v1, 2, 2
    v_lshl_add_u32 v12, v12, 3, v13
    v_mul_u32_u24 v3, 56, v12
    v_bfe_u32 v12, v1, 4, 1
    v_lshl_add_u32 v3, v12, 5, v3
    v_and_b32 v13, 3, v1
    v_lshl_add_u32 v3, v13, 3, v3
    v_lshl_add_u32 v12, v12, 2, v13
    v_cmp_eq_u32 vcc, 7, v12
    v_mov_b32 v13, 1024
    s_nop 1
    v_cndmask_b32 v3, v3, v13, vcc
    v_and_b32 v12, 1, v1
    v_mul_u32_u24 v13, 224, v12
    v_bfe_u32 v12, v1, 1, 1
    v_mul_u32_u24 v12, 1280, v12
    v_add_u32 v13, v13, v12
    v_bfe_u32 v12, v1, 2, 2
    v_min_u32 v12, 2, v12
    v_mul_u32_u24 v12, 36864, v12
    v_add_u32 v13, v13, v12
    s_add_u32 s40, s49, 1024
    v_add_u32 v13, s40, v13
    v_mov_b32 v154, 0x3f80
    v_mov_b32 v155, 0
    ds_write_b64 v13, v[154:155]
    v_mov_b32 v175, 0x3f80
    s_waitcnt lgkmcnt(0)
    s_lshl_b32 s42, s42, 4
    s_lshr_b32 s38, s38, s42
    s_lshl_b32 s38, s38, 16
    s_and_b32 s40, s38, 0x7fffffff
    s_cmp_gt_u32 s40, 0x41300000
    s_cbranch_scc1 L_slow
    s_add_u32 s51, s34, 14336
    s_add_u32 s34, s34, 28672
    s_mov_b32 s48, s34
    v_mov_b32 v16, s38
    v_mul_f32 v16, 0x3fb8aa3b, v16
    v_mul_f32 v12, -0.5, v16
    v_or_b32 v12, 0x80000000, v12
    v_cvt_pk_bf16_f32 v25, v12, 0
    v_and_b32 v25, 0xffff, v25
    v_mov_b32 v33, v25
    v_mov_b32 v50, 0
    v_mov_b32 v51, 0
    v_mov_b32 v52, 0
    v_mov_b32 v53, 0
    v_mov_b32 v54, 0
    v_mov_b32 v55, 0
    v_mov_b32 v56, 0
    v_mov_b32 v57, 0
    v_mov_b32 v58, 0
    v_mov_b32 v59, 0
    v_mov_b32 v60, 0
    v_mov_b32 v61, 0
    v_mov_b32 v62, 0
    v_mov_b32 v63, 0
    v_mov_b32 v64, 0
    v_mov_b32 v65, 0
    v_mov_b32 v66, 0
    v_mov_b32 v67, 0
    v_mov_b32 v68, 0
    v_mov_b32 v69, 0
    v_mov_b32 v70, 0
    v_mov_b32 v71, 0
    v_mov_b32 v72, 0
    v_mov_b32 v73, 0
    v_mov_b32 v74, 0
    v_mov_b32 v75, 0
    v_mov_b32 v76, 0
    v_mov_b32 v77, 0
    v_mov_b32 v78, 0
    v_mov_b32 v79, 0
    v_mov_b32 v80, 0
    v_mov_b32 v81, 0
    v_mov_b32 v46, 0
    v_mov_b32 v47, 0
    v_mov_b32 v48, 0
    v_mov_b32 v49, 0
    v_mov_b32 v138, 0
    v_mov_b32 v139, 0
    v_mov_b32 v140, 0
    v_mov_b32 v141, 0
    v_mov_b32 v142, 0
    v_mov_b32 v143, 0
    v_mov_b32 v144, 0
    v_mov_b32 v145, 0
    s_waitcnt vmcnt(5)
    v_dot2_f32_bf16 v12, v82, v82, 0
    v_dot2_f32_bf16 v13, v83, v83, 0
    v_dot2_f32_bf16 v12, v84, v84, v12
    v_dot2_f32_bf16 v13, v85, v85, v13
    s_waitcnt vmcnt(4)
    v_dot2_f32_bf16 v12, v86, v86, v12
    v_dot2_f32_bf16 v13, v87, v87, v13
    v_dot2_f32_bf16 v12, v88, v88, v12
    v_lshlrev_b32 v154, 16, v82
    v_and_b32 v155, 0xffff0000, v82
    v_lshlrev_b32 v156, 16, v83
    v_and_b32 v157, 0xffff0000, v83
    v_lshlrev_b32 v158, 16, v84
    v_and_b32 v159, 0xffff0000, v84
    v_lshlrev_b32 v160, 16, v85
    v_and_b32 v161, 0xffff0000, v85
    v_lshlrev_b32 v162, 16, v86
    v_and_b32 v163, 0xffff0000, v86
    v_lshlrev_b32 v164, 16, v87
    v_and_b32 v165, 0xffff0000, v87
    v_lshlrev_b32 v166, 16, v88
    v_and_b32 v167, 0xffff0000, v88
    buffer_load_dwordx4 v[106:109], v7, s[16:19], s39 offen offset:1792
    buffer_load_dwordx3 v[110:112], v7, s[16:19], s39 offen offset:1808
    buffer_load_dwordx4 v[146:149], v7, s[20:23], s51 offen
    buffer_load_dwordx3 v[150:152], v7, s[20:23], s51 offen offset:16
    s_add_u32 s50, s49, 36864
    s_mov_b32 m0, s50
    s_nop 0
    buffer_load_dwordx4 v5, s[24:27], s51 offen lds
    s_add_u32 m0, s50, 384
    s_nop 0
    buffer_load_dwordx4 v5, s[24:27], s51 offen offset:896 lds
    s_add_u32 s49, s49, 73728
    v_add_f32 v12, v12, v13
    v_mov_b32 v13, v12
    s_nop 1
    v_permlane32_swap_b32 v12, v13
    v_add_f32 v12, v12, v13
    v_sqrt_f32 v12, v12
    s_nop 0
    v_add_f32 v12, 0x358637bd, v12
    v_rcp_f32 v14, v12
    s_nop 0
    v_pk_mul_f32 v[154:155], v[154:155], v[14:15] op_sel_hi:[1,0]
    v_cvt_pk_bf16_f32 v168, v154, v155
    v_pk_mul_f32 v[156:157], v[156:157], v[14:15] op_sel_hi:[1,0]
    v_cvt_pk_bf16_f32 v169, v156, v157
    v_pk_mul_f32 v[158:159], v[158:159], v[14:15] op_sel_hi:[1,0]
    v_cvt_pk_bf16_f32 v170, v158, v159
    v_pk_mul_f32 v[160:161], v[160:161], v[14:15] op_sel_hi:[1,0]
    v_cvt_pk_bf16_f32 v171, v160, v161
    v_pk_mul_f32 v[162:163], v[162:163], v[14:15] op_sel_hi:[1,0]
    v_cvt_pk_bf16_f32 v172, v162, v163
    v_pk_mul_f32 v[164:165], v[164:165], v[14:15] op_sel_hi:[1,0]
    v_cvt_pk_bf16_f32 v173, v164, v165
    v_pk_mul_f32 v[166:167], v[166:167], v[14:15] op_sel_hi:[1,0]
    v_cvt_pk_bf16_f32 v174, v166, v167
    ds_write_b128 v6, v[168:171] offset:0
    ds_write_b128 v6, v[172:175] offset:1024
    v_add_u32 v4, 36864, v2
    v_add_u32 v8, 36864, v3
    s_waitcnt vmcnt(9)
    v_dot2_f32_bf16 v12, v98, v98, 0
    v_dot2_f32_bf16 v13, v99, v99, 0
    v_dot2_f32_bf16 v12, v100, v100, v12
    v_dot2_f32_bf16 v13, v101, v101, v13
    s_waitcnt vmcnt(8)
    v_dot2_f32_bf16 v12, v102, v102, v12
    v_dot2_f32_bf16 v13, v103, v103, v13
    v_dot2_f32_bf16 v12, v104, v104, v12
    v_lshlrev_b32 v154, 16, v98
    v_and_b32 v155, 0xffff0000, v98
    v_lshlrev_b32 v156, 16, v99
    v_and_b32 v157, 0xffff0000, v99
    v_lshlrev_b32 v158, 16, v100
    v_and_b32 v159, 0xffff0000, v100
    v_lshlrev_b32 v160, 16, v101
    v_and_b32 v161, 0xffff0000, v101
    v_lshlrev_b32 v162, 16, v102
    v_and_b32 v163, 0xffff0000, v102
    v_lshlrev_b32 v164, 16, v103
    v_and_b32 v165, 0xffff0000, v103
    v_lshlrev_b32 v166, 16, v104
    v_and_b32 v167, 0xffff0000, v104
    v_add_f32 v12, v12, v13
    v_mov_b32 v13, v12
    s_nop 1
    v_permlane32_swap_b32 v12, v13
    v_add_f32 v12, v12, v13
    v_sqrt_f32 v12, v12
    s_nop 0
    v_add_f32 v12, 0x358637bd, v12
    v_rcp_f32 v14, v12
    s_nop 0
    v_mul_f32 v14, v14, v16
    v_pk_mul_f32 v[154:155], v[154:155], v[14:15] op_sel_hi:[1,0]
    v_cvt_pk_bf16_f32 v18, v154, v155
    v_pk_mul_f32 v[156:157], v[156:157], v[14:15] op_sel_hi:[1,0]
    v_cvt_pk_bf16_f32 v19, v156, v157
    v_pk_mul_f32 v[158:159], v[158:159], v[14:15] op_sel_hi:[1,0]
    v_cvt_pk_bf16_f32 v20, v158, v159
    v_pk_mul_f32 v[160:161], v[160:161], v[14:15] op_sel_hi:[1,0]
    v_cvt_pk_bf16_f32 v21, v160, v161
    v_pk_mul_f32 v[162:163], v[162:163], v[14:15] op_sel_hi:[1,0]
    v_cvt_pk_bf16_f32 v22, v162, v163
    v_pk_mul_f32 v[164:165], v[164:165], v[14:15] op_sel_hi:[1,0]
    v_cvt_pk_bf16_f32 v23, v164, v165
    v_pk_mul_f32 v[166:167], v[166:167], v[14:15] op_sel_hi:[1,0]
    v_cvt_pk_bf16_f32 v24, v166, v167
    v_add_u32 v6, 36864, v6
    s_mov_b32 s36, 1
    s_mov_b32 s43, 36864
    s_waitcnt vmcnt(7)
    s_waitcnt vmcnt(6)
    s_waitcnt lgkmcnt(0)
    s_barrier
    ds_read_b128 v[34:37], v2 offset:0
    ds_read_b128 v[38:41], v2 offset:1024
    ds_read_b64_tr_b16 v[42:43], v3 offset:16384
    ds_read_b64_tr_b16 v[44:45], v3 offset:16608
    s_waitcnt vmcnt(5)
    v_dot2_f32_bf16 v12, v106, v106, 0
    v_dot2_f32_bf16 v13, v107, v107, 0
    v_dot2_f32_bf16 v12, v108, v108, v12
    v_dot2_f32_bf16 v13, v109, v109, v13
    s_waitcnt vmcnt(4)
    v_dot2_f32_bf16 v12, v110, v110, v12
    v_dot2_f32_bf16 v13, v111, v111, v13
    v_dot2_f32_bf16 v12, v112, v112, v12
    v_lshlrev_b32 v154, 16, v106
    v_and_b32 v155, 0xffff0000, v106
    v_lshlrev_b32 v156, 16, v107
    v_and_b32 v157, 0xffff0000, v107
    v_lshlrev_b32 v158, 16, v108
    v_and_b32 v159, 0xffff0000, v108
    v_lshlrev_b32 v160, 16, v109
    v_and_b32 v161, 0xffff0000, v109
    v_lshlrev_b32 v162, 16, v110
    v_and_b32 v163, 0xffff0000, v110
    v_lshlrev_b32 v164, 16, v111
    v_and_b32 v165, 0xffff0000, v111
    v_lshlrev_b32 v166, 16, v112
    v_and_b32 v167, 0xffff0000, v112
    s_waitcnt lgkmcnt(3)
    v_mfma_f32_32x32x16_bf16 v[82:97], v[34:37], v[18:21], 0
    s_waitcnt lgkmcnt(2)
    v_mfma_f32_32x32x16_bf16 v[82:97], v[38:41], v[22:25], v[82:97]
    v_add_f32 v12, v12, v13
    v_mov_b32 v13, v12
    s_nop 1
    v_permlane32_swap_b32 v12, v13
    v_add_f32 v12, v12, v13
    v_sqrt_f32 v12, v12
    s_nop 0
    v_add_f32 v12, 0x358637bd, v12
    v_rcp_f32 v14, v12
    s_nop 0
    v_mul_f32 v14, v14, v16
    v_pk_mul_f32 v[154:155], v[154:155], v[14:15] op_sel_hi:[1,0]
    v_cvt_pk_bf16_f32 v26, v154, v155
    v_pk_mul_f32 v[156:157], v[156:157], v[14:15] op_sel_hi:[1,0]
    v_cvt_pk_bf16_f32 v27, v156, v157
    v_pk_mul_f32 v[158:159], v[158:159], v[14:15] op_sel_hi:[1,0]
    v_cvt_pk_bf16_f32 v28, v158, v159
    v_pk_mul_f32 v[160:161], v[160:161], v[14:15] op_sel_hi:[1,0]
    v_cvt_pk_bf16_f32 v29, v160, v161
    v_pk_mul_f32 v[162:163], v[162:163], v[14:15] op_sel_hi:[1,0]
    v_cvt_pk_bf16_f32 v30, v162, v163
    v_pk_mul_f32 v[164:165], v[164:165], v[14:15] op_sel_hi:[1,0]
    v_cvt_pk_bf16_f32 v31, v164, v165
    v_pk_mul_f32 v[166:167], v[166:167], v[14:15] op_sel_hi:[1,0]
    v_cvt_pk_bf16_f32 v32, v166, v167
    v_mfma_f32_32x32x16_bf16 v[114:129], v[34:37], v[26:29], 0
    s_nop 0
    v_mfma_f32_32x32x16_bf16 v[114:129], v[38:41], v[30:33], v[114:129]
    ds_read_b128 v[34:37], v2 offset:2048
    ds_read_b128 v[38:41], v2 offset:3072
    s_mov_b32 s35, 7
    s_waitcnt lgkmcnt(0)
    s_nop 15
.p2align 6
L_loop:
    s_waitcnt lgkmcnt(3)
    v_mfma_f32_32x32x16_bf16 v[98:113], v[34:37], v[18:21], 0
    v_exp_f32 v82, v82
    v_exp_f32 v83, v83
    s_waitcnt vmcnt(3)
    v_dot2_f32_bf16 v12, v146, v146, 0
    v_exp_f32 v84, v84
    v_exp_f32 v85, v85
    v_dot2_f32_bf16 v13, v147, v147, 0
    v_smfmac_f32_32x32x32_bf16 v[66:81], v[46:49], v[138:145], v9
    ds_read_b64_tr_b16 v[46:47], v3 offset:17664
    ds_read_b64_tr_b16 v[48:49], v3 offset:17888
    v_exp_f32 v86, v86
    v_exp_f32 v87, v87
    v_exp_f32 v88, v88
    v_exp_f32 v89, v89
    v_dot2_f32_bf16 v12, v148, v148, v12
    v_mfma_f32_32x32x16_bf16 v[130:145], v[34:37], v[26:29], 0
    ds_read_b128 v[34:37], v2 offset:4096
    v_exp_f32 v90, v90
    v_exp_f32 v91, v91
    v_dot2_f32_bf16 v13, v149, v149, v13
    v_exp_f32 v92, v92
    v_exp_f32 v93, v93
    s_waitcnt vmcnt(2)
    v_dot2_f32_bf16 v12, v150, v150, v12
    s_waitcnt lgkmcnt(3)
    v_smfmac_f32_32x32x32_bf16 v[50:65], v[42:45], v[82:89], v9
    v_exp_f32 v94, v94
    v_exp_f32 v95, v95
    v_exp_f32 v96, v96
    v_exp_f32 v97, v97
    v_dot2_f32_bf16 v13, v151, v151, v13
    v_mfma_f32_32x32x16_bf16 v[98:113], v[38:41], v[22:25], v[98:113]
    v_exp_f32 v114, v114
    v_exp_f32 v115, v115
    v_dot2_f32_bf16 v12, v152, v152, v12
    v_exp_f32 v116, v116
    v_exp_f32 v117, v117
    v_lshlrev_b32 v154, 16, v146
    v_mfma_f32_32x32x16_bf16 v[130:145], v[38:41], v[30:33], v[130:145]
    ds_read_b128 v[38:41], v2 offset:5120
    v_exp_f32 v118, v118
    v_exp_f32 v119, v119
    v_exp_f32 v120, v120
    v_exp_f32 v121, v121
    v_and_b32 v155, 0xffff0000, v146
    s_waitcnt lgkmcnt(2)
    v_smfmac_f32_32x32x32_bf16 v[50:65], v[46:49], v[90:97], v9
    v_exp_f32 v122, v122
    v_exp_f32 v123, v123
    v_lshlrev_b32 v156, 16, v147
    v_exp_f32 v124, v124
    v_exp_f32 v125, v125
    v_and_b32 v157, 0xffff0000, v147
    v_smfmac_f32_32x32x32_bf16 v[66:81], v[42:45], v[114:121], v9
    ds_read_b64_tr_b16 v[42:43], v3 offset:18944
    ds_read_b64_tr_b16 v[44:45], v3 offset:19168
    v_exp_f32 v126, v126
    v_exp_f32 v127, v127
    v_exp_f32 v128, v128
    v_exp_f32 v129, v129
    v_lshlrev_b32 v158, 16, v148
    s_setprio 2
    s_waitcnt lgkmcnt(3)
    v_mfma_f32_32x32x16_bf16 v[82:97], v[34:37], v[18:21], 0
    v_exp_f32 v98, v98
    v_exp_f32 v99, v99
    v_and_b32 v159, 0xffff0000, v148
    v_exp_f32 v100, v100
    v_exp_f32 v101, v101
    v_lshlrev_b32 v160, 16, v149
    v_smfmac_f32_32x32x32_bf16 v[66:81], v[46:49], v[122:129], v9
    ds_read_b64_tr_b16 v[46:47], v3 offset:20224
    ds_read_b64_tr_b16 v[48:49], v3 offset:20448
    v_exp_f32 v102, v102
    v_exp_f32 v103, v103
    v_exp_f32 v104, v104
    v_exp_f32 v105, v105
    v_and_b32 v161, 0xffff0000, v149
    v_mfma_f32_32x32x16_bf16 v[114:129], v[34:37], v[26:29], 0
    ds_read_b128 v[34:37], v2 offset:6144
    v_exp_f32 v106, v106
    v_exp_f32 v107, v107
    v_lshlrev_b32 v162, 16, v150
    v_exp_f32 v108, v108
    v_exp_f32 v109, v109
    v_and_b32 v163, 0xffff0000, v150
    s_waitcnt lgkmcnt(3)
    v_smfmac_f32_32x32x32_bf16 v[50:65], v[42:45], v[98:105], v9
    v_exp_f32 v110, v110
    v_exp_f32 v111, v111
    v_exp_f32 v112, v112
    v_exp_f32 v113, v113
    v_lshlrev_b32 v164, 16, v151
    v_mfma_f32_32x32x16_bf16 v[82:97], v[38:41], v[22:25], v[82:97]
    v_exp_f32 v130, v130
    v_exp_f32 v131, v131
    v_and_b32 v165, 0xffff0000, v151
    v_exp_f32 v132, v132
    v_exp_f32 v133, v133
    v_lshlrev_b32 v166, 16, v152
    v_mfma_f32_32x32x16_bf16 v[114:129], v[38:41], v[30:33], v[114:129]
    ds_read_b128 v[38:41], v2 offset:7168
    v_exp_f32 v134, v134
    v_exp_f32 v135, v135
    v_exp_f32 v136, v136
    v_exp_f32 v137, v137
    v_and_b32 v167, 0xffff0000, v152
    s_waitcnt lgkmcnt(2)
    v_smfmac_f32_32x32x32_bf16 v[50:65], v[46:49], v[106:113], v9
    v_exp_f32 v138, v138
    v_exp_f32 v139, v139
    buffer_load_dwordx4 v[146:149], v7, s[20:23], s34 offen
    v_exp_f32 v140, v140
    v_exp_f32 v141, v141
    buffer_load_dwordx3 v[150:152], v7, s[20:23], s34 offen offset:16
    v_smfmac_f32_32x32x32_bf16 v[66:81], v[42:45], v[130:137], v9
    ds_read_b64_tr_b16 v[42:43], v3 offset:21504
    ds_read_b64_tr_b16 v[44:45], v3 offset:21728
    v_exp_f32 v142, v142
    v_exp_f32 v143, v143
    v_exp_f32 v144, v144
    v_exp_f32 v145, v145
    s_add_u32 s34, s34, 14336
    s_waitcnt lgkmcnt(3)
    v_mfma_f32_32x32x16_bf16 v[98:113], v[34:37], v[18:21], 0
    v_exp_f32 v82, v82
    v_exp_f32 v83, v83
    v_exp_f32 v84, v84
    v_exp_f32 v85, v85
    v_add_f32 v12, v12, v13
    v_smfmac_f32_32x32x32_bf16 v[66:81], v[46:49], v[138:145], v9
    ds_read_b64_tr_b16 v[46:47], v3 offset:22784
    ds_read_b64_tr_b16 v[48:49], v3 offset:23008
    v_exp_f32 v86, v86
    v_exp_f32 v87, v87
    v_mov_b32 v13, v12
    v_exp_f32 v88, v88
    v_exp_f32 v89, v89
    v_permlane32_swap_b32 v12, v13
    v_mfma_f32_32x32x16_bf16 v[130:145], v[34:37], v[26:29], 0
    ds_read_b128 v[34:37], v2 offset:8192
    v_exp_f32 v90, v90
    v_exp_f32 v91, v91
    v_exp_f32 v92, v92
    v_exp_f32 v93, v93
    v_add_f32 v12, v12, v13
    s_waitcnt lgkmcnt(3)
    v_smfmac_f32_32x32x32_bf16 v[50:65], v[42:45], v[82:89], v9
    v_exp_f32 v94, v94
    v_exp_f32 v95, v95
    v_sqrt_f32 v12, v12
    v_exp_f32 v96, v96
    v_exp_f32 v97, v97
    v_add_f32 v12, 0x358637bd, v12
    v_mfma_f32_32x32x16_bf16 v[98:113], v[38:41], v[22:25], v[98:113]
    v_exp_f32 v114, v114
    v_exp_f32 v115, v115
    v_exp_f32 v116, v116
    v_exp_f32 v117, v117
    v_rcp_f32 v14, v12
    v_mfma_f32_32x32x16_bf16 v[130:145], v[38:41], v[30:33], v[130:145]
    ds_read_b128 v[38:41], v2 offset:9216
    v_exp_f32 v118, v118
    v_exp_f32 v119, v119
    v_pk_mul_f32 v[154:155], v[154:155], v[14:15] op_sel_hi:[1,0]
    v_exp_f32 v120, v120
    v_exp_f32 v121, v121
    v_cvt_pk_bf16_f32 v168, v154, v155
    s_waitcnt lgkmcnt(2)
    v_smfmac_f32_32x32x32_bf16 v[50:65], v[46:49], v[90:97], v9
    v_exp_f32 v122, v122
    v_exp_f32 v123, v123
    v_exp_f32 v124, v124
    v_exp_f32 v125, v125
    v_pk_mul_f32 v[156:157], v[156:157], v[14:15] op_sel_hi:[1,0]
    v_smfmac_f32_32x32x32_bf16 v[66:81], v[42:45], v[114:121], v9
    ds_read_b64_tr_b16 v[42:43], v3 offset:24064
    ds_read_b64_tr_b16 v[44:45], v3 offset:24288
    v_exp_f32 v126, v126
    v_exp_f32 v127, v127
    v_cvt_pk_bf16_f32 v169, v156, v157
    v_exp_f32 v128, v128
    v_exp_f32 v129, v129
    v_pk_mul_f32 v[158:159], v[158:159], v[14:15] op_sel_hi:[1,0]
    s_setprio 1
    s_waitcnt lgkmcnt(3)
    v_mfma_f32_32x32x16_bf16 v[82:97], v[34:37], v[18:21], 0
    v_exp_f32 v98, v98
    v_exp_f32 v99, v99
    v_exp_f32 v100, v100
    v_exp_f32 v101, v101
    v_cvt_pk_bf16_f32 v170, v158, v159
    v_smfmac_f32_32x32x32_bf16 v[66:81], v[46:49], v[122:129], v9
    ds_read_b64_tr_b16 v[46:47], v3 offset:25344
    ds_read_b64_tr_b16 v[48:49], v3 offset:25568
    v_exp_f32 v102, v102
    v_exp_f32 v103, v103
    v_pk_mul_f32 v[160:161], v[160:161], v[14:15] op_sel_hi:[1,0]
    v_exp_f32 v104, v104
    v_exp_f32 v105, v105
    v_cvt_pk_bf16_f32 v171, v160, v161
    v_mfma_f32_32x32x16_bf16 v[114:129], v[34:37], v[26:29], 0
    ds_read_b128 v[34:37], v2 offset:10240
    v_exp_f32 v106, v106
    v_exp_f32 v107, v107
    v_exp_f32 v108, v108
    v_exp_f32 v109, v109
    v_pk_mul_f32 v[162:163], v[162:163], v[14:15] op_sel_hi:[1,0]
    s_waitcnt lgkmcnt(3)
    v_smfmac_f32_32x32x32_bf16 v[50:65], v[42:45], v[98:105], v9
    v_exp_f32 v110, v110
    v_exp_f32 v111, v111
    v_cvt_pk_bf16_f32 v172, v162, v163
    v_exp_f32 v112, v112
    v_exp_f32 v113, v113
    v_pk_mul_f32 v[164:165], v[164:165], v[14:15] op_sel_hi:[1,0]
    v_mfma_f32_32x32x16_bf16 v[82:97], v[38:41], v[22:25], v[82:97]
    v_exp_f32 v130, v130
    v_exp_f32 v131, v131
    v_exp_f32 v132, v132
    v_exp_f32 v133, v133
    v_cvt_pk_bf16_f32 v173, v164, v165
    v_mfma_f32_32x32x16_bf16 v[114:129], v[38:41], v[30:33], v[114:129]
    ds_read_b128 v[38:41], v2 offset:11264
    v_exp_f32 v134, v134
    v_exp_f32 v135, v135
    v_pk_mul_f32 v[166:167], v[166:167], v[14:15] op_sel_hi:[1,0]
    v_exp_f32 v136, v136
    v_exp_f32 v137, v137
    v_cvt_pk_bf16_f32 v174, v166, v167
    s_waitcnt lgkmcnt(2)
    v_smfmac_f32_32x32x32_bf16 v[50:65], v[46:49], v[106:113], v9
    v_exp_f32 v138, v138
    v_exp_f32 v139, v139
    v_exp_f32 v140, v140
    v_exp_f32 v141, v141
    ds_write_b128 v6, v[168:171] offset:0
    v_smfmac_f32_32x32x32_bf16 v[66:81], v[42:45], v[130:137], v9
    ds_read_b64_tr_b16 v[42:43], v3 offset:26624
    ds_read_b64_tr_b16 v[44:45], v3 offset:26848
    v_exp_f32 v142, v142
    v_exp_f32 v143, v143
    v_exp_f32 v144, v144
    v_exp_f32 v145, v145
    ds_write_b128 v6, v[172:175] offset:1024
    s_waitcnt lgkmcnt(5)
    v_mfma_f32_32x32x16_bf16 v[98:113], v[34:37], v[18:21], 0
    v_exp_f32 v82, v82
    v_exp_f32 v83, v83
    v_exp_f32 v84, v84
    v_exp_f32 v85, v85
    v_smfmac_f32_32x32x32_bf16 v[66:81], v[46:49], v[138:145], v9
    ds_read_b64_tr_b16 v[46:47], v3 offset:27904
    ds_read_b64_tr_b16 v[48:49], v3 offset:28128
    v_exp_f32 v86, v86
    v_exp_f32 v87, v87
    v_exp_f32 v88, v88
    v_exp_f32 v89, v89
    v_mfma_f32_32x32x16_bf16 v[130:145], v[34:37], v[26:29], 0
    ds_read_b128 v[34:37], v2 offset:12288
    v_exp_f32 v90, v90
    v_exp_f32 v91, v91
    v_exp_f32 v92, v92
    v_exp_f32 v93, v93
    s_waitcnt lgkmcnt(4)
    v_smfmac_f32_32x32x32_bf16 v[50:65], v[42:45], v[82:89], v9
    v_exp_f32 v94, v94
    v_exp_f32 v95, v95
    v_exp_f32 v96, v96
    v_exp_f32 v97, v97
    v_mfma_f32_32x32x16_bf16 v[98:113], v[38:41], v[22:25], v[98:113]
    v_exp_f32 v114, v114
    v_exp_f32 v115, v115
    v_exp_f32 v116, v116
    v_exp_f32 v117, v117
    v_mfma_f32_32x32x16_bf16 v[130:145], v[38:41], v[30:33], v[130:145]
    ds_read_b128 v[38:41], v2 offset:13312
    v_exp_f32 v118, v118
    v_exp_f32 v119, v119
    v_exp_f32 v120, v120
    v_exp_f32 v121, v121
    s_waitcnt lgkmcnt(2)
    v_smfmac_f32_32x32x32_bf16 v[50:65], v[46:49], v[90:97], v9
    v_exp_f32 v122, v122
    v_exp_f32 v123, v123
    v_exp_f32 v124, v124
    v_exp_f32 v125, v125
    v_smfmac_f32_32x32x32_bf16 v[66:81], v[42:45], v[114:121], v9
    ds_read_b64_tr_b16 v[42:43], v3 offset:29184
    ds_read_b64_tr_b16 v[44:45], v3 offset:29408
    v_exp_f32 v126, v126
    v_exp_f32 v127, v127
    v_exp_f32 v128, v128
    v_exp_f32 v129, v129
    s_setprio 0
    s_waitcnt lgkmcnt(3)
    v_mfma_f32_32x32x16_bf16 v[82:97], v[34:37], v[18:21], 0
    v_exp_f32 v98, v98
    v_exp_f32 v99, v99
    v_exp_f32 v100, v100
    v_exp_f32 v101, v101
    v_smfmac_f32_32x32x32_bf16 v[66:81], v[46:49], v[122:129], v9
    ds_read_b64_tr_b16 v[46:47], v3 offset:30464
    ds_read_b64_tr_b16 v[48:49], v3 offset:30688
    v_exp_f32 v102, v102
    v_exp_f32 v103, v103
    v_exp_f32 v104, v104
    v_exp_f32 v105, v105
    v_mfma_f32_32x32x16_bf16 v[114:129], v[34:37], v[26:29], 0
    ds_read_b128 v[34:37], v2 offset:14336
    v_exp_f32 v106, v106
    v_exp_f32 v107, v107
    v_exp_f32 v108, v108
    v_exp_f32 v109, v109
    s_waitcnt lgkmcnt(3)
    v_smfmac_f32_32x32x32_bf16 v[50:65], v[42:45], v[98:105], v9
    v_exp_f32 v110, v110
    v_exp_f32 v111, v111
    v_exp_f32 v112, v112
    v_exp_f32 v113, v113
    v_mfma_f32_32x32x16_bf16 v[82:97], v[38:41], v[22:25], v[82:97]
    v_exp_f32 v130, v130
    v_exp_f32 v131, v131
    v_exp_f32 v132, v132
    v_exp_f32 v133, v133
    v_mfma_f32_32x32x16_bf16 v[114:129], v[38:41], v[30:33], v[114:129]
    ds_read_b128 v[38:41], v2 offset:15360
    v_exp_f32 v134, v134
    v_exp_f32 v135, v135
    v_exp_f32 v136, v136
    v_exp_f32 v137, v137
    s_waitcnt lgkmcnt(2)
    v_smfmac_f32_32x32x32_bf16 v[50:65], v[46:49], v[106:113], v9
    v_exp_f32 v138, v138
    v_exp_f32 v139, v139
    v_exp_f32 v140, v140
    v_exp_f32 v141, v141
    v_smfmac_f32_32x32x32_bf16 v[66:81], v[42:45], v[130:137], v9
    ds_read_b64_tr_b16 v[42:43], v3 offset:31744
    ds_read_b64_tr_b16 v[44:45], v3 offset:31968
    v_exp_f32 v142, v142
    v_exp_f32 v143, v143
    v_exp_f32 v144, v144
    v_exp_f32 v145, v145
    s_waitcnt vmcnt(3)
    s_waitcnt vmcnt(2)
    s_barrier
    s_setprio 3
    s_waitcnt lgkmcnt(3)
    v_mfma_f32_32x32x16_bf16 v[98:113], v[34:37], v[18:21], 0
    v_exp_f32 v82, v82
    v_exp_f32 v83, v83
    v_exp_f32 v84, v84
    v_exp_f32 v85, v85
    v_smfmac_f32_32x32x32_bf16 v[66:81], v[46:49], v[138:145], v9
    ds_read_b64_tr_b16 v[46:47], v3 offset:33024
    ds_read_b64_tr_b16 v[48:49], v3 offset:33248
    v_exp_f32 v86, v86
    v_exp_f32 v87, v87
    v_exp_f32 v88, v88
    v_exp_f32 v89, v89
    v_mfma_f32_32x32x16_bf16 v[130:145], v[34:37], v[26:29], 0
    ds_read_b128 v[34:37], v4 offset:0
    v_exp_f32 v90, v90
    v_exp_f32 v91, v91
    v_exp_f32 v92, v92
    v_exp_f32 v93, v93
    s_waitcnt lgkmcnt(3)
    v_smfmac_f32_32x32x32_bf16 v[50:65], v[42:45], v[82:89], v9
    v_exp_f32 v94, v94
    v_exp_f32 v95, v95
    v_exp_f32 v96, v96
    v_exp_f32 v97, v97
    v_mfma_f32_32x32x16_bf16 v[98:113], v[38:41], v[22:25], v[98:113]
    v_exp_f32 v114, v114
    v_exp_f32 v115, v115
    v_exp_f32 v116, v116
    v_exp_f32 v117, v117
    v_mfma_f32_32x32x16_bf16 v[130:145], v[38:41], v[30:33], v[130:145]
    ds_read_b128 v[38:41], v4 offset:1024
    v_exp_f32 v118, v118
    v_exp_f32 v119, v119
    v_exp_f32 v120, v120
    v_exp_f32 v121, v121
    s_waitcnt lgkmcnt(2)
    v_smfmac_f32_32x32x32_bf16 v[50:65], v[46:49], v[90:97], v9
    v_exp_f32 v122, v122
    v_exp_f32 v123, v123
    v_exp_f32 v124, v124
    v_exp_f32 v125, v125
    v_smfmac_f32_32x32x32_bf16 v[66:81], v[42:45], v[114:121], v9
    ds_read_b64_tr_b16 v[42:43], v3 offset:34304
    ds_read_b64_tr_b16 v[44:45], v3 offset:34528
    v_exp_f32 v126, v126
    v_exp_f32 v127, v127
    v_exp_f32 v128, v128
    v_exp_f32 v129, v129
    s_cmp_eq_u32 s35, 1
    s_cbranch_scc1 L_novA
    s_mov_b32 m0, s49
    s_nop 0
    buffer_load_dwordx4 v5, s[24:27], s48 offen lds
    s_add_u32 m0, s49, 384
    s_nop 0
    buffer_load_dwordx4 v5, s[24:27], s48 offen offset:896 lds
L_novA:
    s_add_u32 s48, s48, 14336
    s_add_u32 s49, s49, 36864
    s_sub_u32 s50, s49, 110592
    s_cmp_ge_u32 s49, 110592
    s_cselect_b32 s49, s50, s49
    s_waitcnt lgkmcnt(3)
    v_mfma_f32_32x32x16_bf16 v[82:97], v[34:37], v[18:21], 0
    v_exp_f32 v98, v98
    v_exp_f32 v99, v99
    v_exp_f32 v100, v100
    v_exp_f32 v101, v101
    v_smfmac_f32_32x32x32_bf16 v[66:81], v[46:49], v[122:129], v9
    ds_read_b64_tr_b16 v[46:47], v3 offset:35584
    ds_read_b64_tr_b16 v[48:49], v3 offset:35808
    v_exp_f32 v102, v102
    v_exp_f32 v103, v103
    v_exp_f32 v104, v104
    v_exp_f32 v105, v105
    v_mfma_f32_32x32x16_bf16 v[114:129], v[34:37], v[26:29], 0
    ds_read_b128 v[34:37], v4 offset:2048
    v_exp_f32 v106, v106
    v_exp_f32 v107, v107
    v_exp_f32 v108, v108
    v_exp_f32 v109, v109
    s_waitcnt lgkmcnt(3)
    v_smfmac_f32_32x32x32_bf16 v[50:65], v[42:45], v[98:105], v9
    v_exp_f32 v110, v110
    v_exp_f32 v111, v111
    v_exp_f32 v112, v112
    v_exp_f32 v113, v113
    v_mfma_f32_32x32x16_bf16 v[82:97], v[38:41], v[22:25], v[82:97]
    v_exp_f32 v130, v130
    v_exp_f32 v131, v131
    v_exp_f32 v132, v132
    v_exp_f32 v133, v133
    v_mfma_f32_32x32x16_bf16 v[114:129], v[38:41], v[30:33], v[114:129]
    ds_read_b128 v[38:41], v4 offset:3072
    v_exp_f32 v134, v134
    v_exp_f32 v135, v135
    v_exp_f32 v136, v136
    v_exp_f32 v137, v137
    s_waitcnt lgkmcnt(2)
    v_smfmac_f32_32x32x32_bf16 v[50:65], v[46:49], v[106:113], v9
    v_exp_f32 v138, v138
    v_exp_f32 v139, v139
    v_exp_f32 v140, v140
    v_exp_f32 v141, v141
    v_smfmac_f32_32x32x32_bf16 v[66:81], v[42:45], v[130:137], v9
    ds_read_b64_tr_b16 v[42:43], v8 offset:16384
    ds_read_b64_tr_b16 v[44:45], v8 offset:16608
    v_exp_f32 v142, v142
    v_exp_f32 v143, v143
    v_exp_f32 v144, v144
    v_exp_f32 v145, v145
    v_mov_b32 v2, v4
    v_mov_b32 v3, v8
    s_add_u32 s36, s36, 1
    s_cmp_eq_u32 s36, 3
    s_cselect_b32 s37, 0xfffee000, s43
    s_cselect_b32 s36, 0, s36
    v_add_u32 v4, s37, v4
    v_add_u32 v8, s37, v8
    v_add_u32 v6, s37, v6
    s_sub_u32 s35, s35, 1
    s_cmp_lg_u32 s35, 0
    s_cbranch_scc1 L_loop
    s_setprio 3
    s_waitcnt lgkmcnt(3)
    v_mfma_f32_32x32x16_bf16 v[98:113], v[34:37], v[18:21], 0
    v_exp_f32 v82, v82
    v_exp_f32 v83, v83
    v_exp_f32 v84, v84
    v_exp_f32 v85, v85
    v_smfmac_f32_32x32x32_bf16 v[66:81], v[46:49], v[138:145], v9
    ds_read_b64_tr_b16 v[46:47], v3 offset:17664
    ds_read_b64_tr_b16 v[48:49], v3 offset:17888
    v_exp_f32 v86, v86
    v_exp_f32 v87, v87
    v_exp_f32 v88, v88
    v_exp_f32 v89, v89
    v_mfma_f32_32x32x16_bf16 v[130:145], v[34:37], v[26:29], 0
    ds_read_b128 v[34:37], v2 offset:4096
    v_exp_f32 v90, v90
    v_exp_f32 v91, v91
    v_exp_f32 v92, v92
    v_exp_f32 v93, v93
    s_waitcnt lgkmcnt(3)
    v_smfmac_f32_32x32x32_bf16 v[50:65], v[42:45], v[82:89], v9
    v_exp_f32 v94, v94
    v_exp_f32 v95, v95
    v_exp_f32 v96, v96
    v_exp_f32 v97, v97
    v_mfma_f32_32x32x16_bf16 v[98:113], v[38:41], v[22:25], v[98:113]
    v_exp_f32 v114, v114
    v_exp_f32 v115, v115
    v_exp_f32 v116, v116
    v_exp_f32 v117, v117
    v_mfma_f32_32x32x16_bf16 v[130:145], v[38:41], v[30:33], v[130:145]
    ds_read_b128 v[38:41], v2 offset:5120
    v_exp_f32 v118, v118
    v_exp_f32 v119, v119
    v_exp_f32 v120, v120
    v_exp_f32 v121, v121
    s_waitcnt lgkmcnt(2)
    v_smfmac_f32_32x32x32_bf16 v[50:65], v[46:49], v[90:97], v9
    v_exp_f32 v122, v122
    v_exp_f32 v123, v123
    v_exp_f32 v124, v124
    v_exp_f32 v125, v125
    v_smfmac_f32_32x32x32_bf16 v[66:81], v[42:45], v[114:121], v9
    ds_read_b64_tr_b16 v[42:43], v3 offset:18944
    ds_read_b64_tr_b16 v[44:45], v3 offset:19168
    v_exp_f32 v126, v126
    v_exp_f32 v127, v127
    v_exp_f32 v128, v128
    v_exp_f32 v129, v129
    s_waitcnt lgkmcnt(3)
    v_mfma_f32_32x32x16_bf16 v[82:97], v[34:37], v[18:21], 0
    v_exp_f32 v98, v98
    v_exp_f32 v99, v99
    v_exp_f32 v100, v100
    v_exp_f32 v101, v101
    v_smfmac_f32_32x32x32_bf16 v[66:81], v[46:49], v[122:129], v9
    ds_read_b64_tr_b16 v[46:47], v3 offset:20224
    ds_read_b64_tr_b16 v[48:49], v3 offset:20448
    v_exp_f32 v102, v102
    v_exp_f32 v103, v103
    v_exp_f32 v104, v104
    v_exp_f32 v105, v105
    v_mfma_f32_32x32x16_bf16 v[114:129], v[34:37], v[26:29], 0
    ds_read_b128 v[34:37], v2 offset:6144
    v_exp_f32 v106, v106
    v_exp_f32 v107, v107
    v_exp_f32 v108, v108
    v_exp_f32 v109, v109
    s_waitcnt lgkmcnt(3)
    v_smfmac_f32_32x32x32_bf16 v[50:65], v[42:45], v[98:105], v9
    v_exp_f32 v110, v110
    v_exp_f32 v111, v111
    v_exp_f32 v112, v112
    v_exp_f32 v113, v113
    v_mfma_f32_32x32x16_bf16 v[82:97], v[38:41], v[22:25], v[82:97]
    v_exp_f32 v130, v130
    v_exp_f32 v131, v131
    v_exp_f32 v132, v132
    v_exp_f32 v133, v133
    v_mfma_f32_32x32x16_bf16 v[114:129], v[38:41], v[30:33], v[114:129]
    ds_read_b128 v[38:41], v2 offset:7168
    v_exp_f32 v134, v134
    v_exp_f32 v135, v135
    v_exp_f32 v136, v136
    v_exp_f32 v137, v137
    s_waitcnt lgkmcnt(2)
    v_smfmac_f32_32x32x32_bf16 v[50:65], v[46:49], v[106:113], v9
    v_exp_f32 v138, v138
    v_exp_f32 v139, v139
    v_exp_f32 v140, v140
    v_exp_f32 v141, v141
    v_smfmac_f32_32x32x32_bf16 v[66:81], v[42:45], v[130:137], v9
    ds_read_b64_tr_b16 v[42:43], v3 offset:21504
    ds_read_b64_tr_b16 v[44:45], v3 offset:21728
    v_exp_f32 v142, v142
    v_exp_f32 v143, v143
    v_exp_f32 v144, v144
    v_exp_f32 v145, v145
    s_waitcnt lgkmcnt(3)
    v_mfma_f32_32x32x16_bf16 v[98:113], v[34:37], v[18:21], 0
    v_exp_f32 v82, v82
    v_exp_f32 v83, v83
    v_exp_f32 v84, v84
    v_exp_f32 v85, v85
    v_smfmac_f32_32x32x32_bf16 v[66:81], v[46:49], v[138:145], v9
    ds_read_b64_tr_b16 v[46:47], v3 offset:22784
    ds_read_b64_tr_b16 v[48:49], v3 offset:23008
    v_exp_f32 v86, v86
    v_exp_f32 v87, v87
    v_exp_f32 v88, v88
    v_exp_f32 v89, v89
    v_mfma_f32_32x32x16_bf16 v[130:145], v[34:37], v[26:29], 0
    ds_read_b128 v[34:37], v2 offset:8192
    v_exp_f32 v90, v90
    v_exp_f32 v91, v91
    v_exp_f32 v92, v92
    v_exp_f32 v93, v93
    s_waitcnt lgkmcnt(3)
    v_smfmac_f32_32x32x32_bf16 v[50:65], v[42:45], v[82:89], v9
    v_exp_f32 v94, v94
    v_exp_f32 v95, v95
    v_exp_f32 v96, v96
    v_exp_f32 v97, v97
    v_mfma_f32_32x32x16_bf16 v[98:113], v[38:41], v[22:25], v[98:113]
    v_exp_f32 v114, v114
    v_exp_f32 v115, v115
    v_exp_f32 v116, v116
    v_exp_f32 v117, v117
    v_mfma_f32_32x32x16_bf16 v[130:145], v[38:41], v[30:33], v[130:145]
    ds_read_b128 v[38:41], v2 offset:9216
    v_exp_f32 v118, v118
    v_exp_f32 v119, v119
    v_exp_f32 v120, v120
    v_exp_f32 v121, v121
    s_waitcnt lgkmcnt(2)
    v_smfmac_f32_32x32x32_bf16 v[50:65], v[46:49], v[90:97], v9
    v_exp_f32 v122, v122
    v_exp_f32 v123, v123
    v_exp_f32 v124, v124
    v_exp_f32 v125, v125
    v_smfmac_f32_32x32x32_bf16 v[66:81], v[42:45], v[114:121], v9
    ds_read_b64_tr_b16 v[42:43], v3 offset:24064
    ds_read_b64_tr_b16 v[44:45], v3 offset:24288
    v_exp_f32 v126, v126
    v_exp_f32 v127, v127
    v_exp_f32 v128, v128
    v_exp_f32 v129, v129
    s_waitcnt lgkmcnt(3)
    v_mfma_f32_32x32x16_bf16 v[82:97], v[34:37], v[18:21], 0
    v_exp_f32 v98, v98
    v_exp_f32 v99, v99
    v_exp_f32 v100, v100
    v_exp_f32 v101, v101
    v_smfmac_f32_32x32x32_bf16 v[66:81], v[46:49], v[122:129], v9
    ds_read_b64_tr_b16 v[46:47], v3 offset:25344
    ds_read_b64_tr_b16 v[48:49], v3 offset:25568
    v_exp_f32 v102, v102
    v_exp_f32 v103, v103
    v_exp_f32 v104, v104
    v_exp_f32 v105, v105
    v_mfma_f32_32x32x16_bf16 v[114:129], v[34:37], v[26:29], 0
    ds_read_b128 v[34:37], v2 offset:10240
    v_exp_f32 v106, v106
    v_exp_f32 v107, v107
    v_exp_f32 v108, v108
    v_exp_f32 v109, v109
    s_waitcnt lgkmcnt(3)
    v_smfmac_f32_32x32x32_bf16 v[50:65], v[42:45], v[98:105], v9
    v_exp_f32 v110, v110
    v_exp_f32 v111, v111
    v_exp_f32 v112, v112
    v_exp_f32 v113, v113
    v_mfma_f32_32x32x16_bf16 v[82:97], v[38:41], v[22:25], v[82:97]
    v_exp_f32 v130, v130
    v_exp_f32 v131, v131
    v_exp_f32 v132, v132
    v_exp_f32 v133, v133
    v_mfma_f32_32x32x16_bf16 v[114:129], v[38:41], v[30:33], v[114:129]
    ds_read_b128 v[38:41], v2 offset:11264
    v_exp_f32 v134, v134
    v_exp_f32 v135, v135
    v_exp_f32 v136, v136
    v_exp_f32 v137, v137
    s_waitcnt lgkmcnt(2)
    v_smfmac_f32_32x32x32_bf16 v[50:65], v[46:49], v[106:113], v9
    v_exp_f32 v138, v138
    v_exp_f32 v139, v139
    v_exp_f32 v140, v140
    v_exp_f32 v141, v141
    v_smfmac_f32_32x32x32_bf16 v[66:81], v[42:45], v[130:137], v9
    ds_read_b64_tr_b16 v[42:43], v3 offset:26624
    ds_read_b64_tr_b16 v[44:45], v3 offset:26848
    v_exp_f32 v142, v142
    v_exp_f32 v143, v143
    v_exp_f32 v144, v144
    v_exp_f32 v145, v145
    s_setprio 2
    s_waitcnt lgkmcnt(3)
    v_mfma_f32_32x32x16_bf16 v[98:113], v[34:37], v[18:21], 0
    v_exp_f32 v82, v82
    v_exp_f32 v83, v83
    v_exp_f32 v84, v84
    v_exp_f32 v85, v85
    v_smfmac_f32_32x32x32_bf16 v[66:81], v[46:49], v[138:145], v9
    ds_read_b64_tr_b16 v[46:47], v3 offset:27904
    ds_read_b64_tr_b16 v[48:49], v3 offset:28128
    v_exp_f32 v86, v86
    v_exp_f32 v87, v87
    v_exp_f32 v88, v88
    v_exp_f32 v89, v89
    v_mfma_f32_32x32x16_bf16 v[130:145], v[34:37], v[26:29], 0
    ds_read_b128 v[34:37], v2 offset:12288
    v_exp_f32 v90, v90
    v_exp_f32 v91, v91
    v_exp_f32 v92, v92
    v_exp_f32 v93, v93
    s_waitcnt lgkmcnt(3)
    v_smfmac_f32_32x32x32_bf16 v[50:65], v[42:45], v[82:89], v9
    v_exp_f32 v94, v94
    v_exp_f32 v95, v95
    v_exp_f32 v96, v96
    v_exp_f32 v97, v97
    v_mfma_f32_32x32x16_bf16 v[98:113], v[38:41], v[22:25], v[98:113]
    v_exp_f32 v114, v114
    v_exp_f32 v115, v115
    v_exp_f32 v116, v116
    v_exp_f32 v117, v117
    v_mfma_f32_32x32x16_bf16 v[130:145], v[38:41], v[30:33], v[130:145]
    ds_read_b128 v[38:41], v2 offset:13312
    v_exp_f32 v118, v118
    v_exp_f32 v119, v119
    v_exp_f32 v120, v120
    v_exp_f32 v121, v121
    s_waitcnt lgkmcnt(2)
    v_smfmac_f32_32x32x32_bf16 v[50:65], v[46:49], v[90:97], v9
    v_exp_f32 v122, v122
    v_exp_f32 v123, v123
    v_exp_f32 v124, v124
    v_exp_f32 v125, v125
    v_smfmac_f32_32x32x32_bf16 v[66:81], v[42:45], v[114:121], v9
    ds_read_b64_tr_b16 v[42:43], v3 offset:29184
    ds_read_b64_tr_b16 v[44:45], v3 offset:29408
    v_exp_f32 v126, v126
    v_exp_f32 v127, v127
    v_exp_f32 v128, v128
    v_exp_f32 v129, v129
    s_waitcnt lgkmcnt(3)
    v_mfma_f32_32x32x16_bf16 v[82:97], v[34:37], v[18:21], 0
    v_exp_f32 v98, v98
    v_exp_f32 v99, v99
    v_exp_f32 v100, v100
    v_exp_f32 v101, v101
    v_smfmac_f32_32x32x32_bf16 v[66:81], v[46:49], v[122:129], v9
    ds_read_b64_tr_b16 v[46:47], v3 offset:30464
    ds_read_b64_tr_b16 v[48:49], v3 offset:30688
    v_exp_f32 v102, v102
    v_exp_f32 v103, v103
    v_exp_f32 v104, v104
    v_exp_f32 v105, v105
    v_mfma_f32_32x32x16_bf16 v[114:129], v[34:37], v[26:29], 0
    ds_read_b128 v[34:37], v2 offset:14336
    v_exp_f32 v106, v106
    v_exp_f32 v107, v107
    v_exp_f32 v108, v108
    v_exp_f32 v109, v109
    s_waitcnt lgkmcnt(3)
    v_smfmac_f32_32x32x32_bf16 v[50:65], v[42:45], v[98:105], v9
    v_exp_f32 v110, v110
    v_exp_f32 v111, v111
    v_exp_f32 v112, v112
    v_exp_f32 v113, v113
    v_mfma_f32_32x32x16_bf16 v[82:97], v[38:41], v[22:25], v[82:97]
    v_exp_f32 v130, v130
    v_exp_f32 v131, v131
    v_exp_f32 v132, v132
    v_exp_f32 v133, v133
    v_mfma_f32_32x32x16_bf16 v[114:129], v[38:41], v[30:33], v[114:129]
    ds_read_b128 v[38:41], v2 offset:15360
    v_exp_f32 v134, v134
    v_exp_f32 v135, v135
    v_exp_f32 v136, v136
    v_exp_f32 v137, v137
    s_waitcnt lgkmcnt(2)
    v_smfmac_f32_32x32x32_bf16 v[50:65], v[46:49], v[106:113], v9
    v_exp_f32 v138, v138
    v_exp_f32 v139, v139
    v_exp_f32 v140, v140
    v_exp_f32 v141, v141
    v_smfmac_f32_32x32x32_bf16 v[66:81], v[42:45], v[130:137], v9
    ds_read_b64_tr_b16 v[42:43], v3 offset:31744
    ds_read_b64_tr_b16 v[44:45], v3 offset:31968
    v_exp_f32 v142, v142
    v_exp_f32 v143, v143
    v_exp_f32 v144, v144
    v_exp_f32 v145, v145
    s_setprio 1
    s_waitcnt lgkmcnt(3)
    v_mfma_f32_32x32x16_bf16 v[98:113], v[34:37], v[18:21], 0
    v_exp_f32 v82, v82
    v_exp_f32 v83, v83
    v_exp_f32 v84, v84
    v_exp_f32 v85, v85
    v_smfmac_f32_32x32x32_bf16 v[66:81], v[46:49], v[138:145], v9
    ds_read_b64_tr_b16 v[46:47], v3 offset:33024
    ds_read_b64_tr_b16 v[48:49], v3 offset:33248
    v_exp_f32 v86, v86
    v_exp_f32 v87, v87
    v_exp_f32 v88, v88
    v_exp_f32 v89, v89
    v_mfma_f32_32x32x16_bf16 v[130:145], v[34:37], v[26:29], 0
    v_exp_f32 v90, v90
    v_exp_f32 v91, v91
    v_exp_f32 v92, v92
    v_exp_f32 v93, v93
    s_waitcnt lgkmcnt(2)
    v_smfmac_f32_32x32x32_bf16 v[50:65], v[42:45], v[82:89], v9
    v_exp_f32 v94, v94
    v_exp_f32 v95, v95
    v_exp_f32 v96, v96
    v_exp_f32 v97, v97
    v_mfma_f32_32x32x16_bf16 v[98:113], v[38:41], v[22:25], v[98:113]
    v_exp_f32 v114, v114
    v_exp_f32 v115, v115
    v_exp_f32 v116, v116
    v_exp_f32 v117, v117
    v_mfma_f32_32x32x16_bf16 v[130:145], v[38:41], v[30:33], v[130:145]
    v_exp_f32 v118, v118
    v_exp_f32 v119, v119
    v_exp_f32 v120, v120
    v_exp_f32 v121, v121
    s_waitcnt lgkmcnt(0)
    v_smfmac_f32_32x32x32_bf16 v[50:65], v[46:49], v[90:97], v9
    v_exp_f32 v122, v122
    v_exp_f32 v123, v123
    v_exp_f32 v124, v124
    v_exp_f32 v125, v125
    v_smfmac_f32_32x32x32_bf16 v[66:81], v[42:45], v[114:121], v9
    ds_read_b64_tr_b16 v[42:43], v3 offset:34304
    ds_read_b64_tr_b16 v[44:45], v3 offset:34528
    v_exp_f32 v126, v126
    v_exp_f32 v127, v127
    v_exp_f32 v128, v128
    v_exp_f32 v129, v129
    s_setprio 0
    v_exp_f32 v98, v98
    v_exp_f32 v99, v99
    v_exp_f32 v100, v100
    v_exp_f32 v101, v101
    v_smfmac_f32_32x32x32_bf16 v[66:81], v[46:49], v[122:129], v9
    ds_read_b64_tr_b16 v[46:47], v3 offset:35584
    ds_read_b64_tr_b16 v[48:49], v3 offset:35808
    v_exp_f32 v102, v102
    v_exp_f32 v103, v103
    v_exp_f32 v104, v104
    v_exp_f32 v105, v105
    v_exp_f32 v106, v106
    v_exp_f32 v107, v107
    v_exp_f32 v108, v108
    v_exp_f32 v109, v109
    s_waitcnt lgkmcnt(2)
    v_smfmac_f32_32x32x32_bf16 v[50:65], v[42:45], v[98:105], v9
    v_exp_f32 v110, v110
    v_exp_f32 v111, v111
    v_exp_f32 v112, v112
    v_exp_f32 v113, v113
    v_exp_f32 v130, v130
    v_exp_f32 v131, v131
    v_exp_f32 v132, v132
    v_exp_f32 v133, v133
    v_exp_f32 v134, v134
    v_exp_f32 v135, v135
    v_exp_f32 v136, v136
    v_exp_f32 v137, v137
    s_waitcnt lgkmcnt(0)
    v_smfmac_f32_32x32x32_bf16 v[50:65], v[46:49], v[106:113], v9
    v_exp_f32 v138, v138
    v_exp_f32 v139, v139
    v_exp_f32 v140, v140
    v_exp_f32 v141, v141
    v_smfmac_f32_32x32x32_bf16 v[66:81], v[42:45], v[130:137], v9
    v_exp_f32 v142, v142
    v_exp_f32 v143, v143
    v_exp_f32 v144, v144
    v_exp_f32 v145, v145
    s_nop 1
    v_smfmac_f32_32x32x32_bf16 v[66:81], v[46:49], v[138:145], v9
    s_lshl_b32 s50, s33, 12
    s_add_u32 s50, s50, 73728
    v_add_u32 v2, s50, v17
    v_add_u32 v4, s50, v5
    v_mov_b32 v12, v62
    v_mov_b32 v13, v62
    s_nop 1
    v_permlane32_swap_b32 v12, v13
    v_rcp_f32 v14, v13
    s_nop 0
    v_mul_f32 v62, v62, v14
    v_mul_f32 v63, v63, v14
    v_mul_f32 v64, v64, v14
    v_mul_f32 v65, v65, v14
    v_cvt_pk_bf16_f32 v160, v62, v63
    v_cvt_pk_bf16_f32 v161, v64, v65
    v_mul_f32 v50, v50, v14
    v_mul_f32 v51, v51, v14
    v_mul_f32 v52, v52, v14
    v_mul_f32 v53, v53, v14
    v_cvt_pk_bf16_f32 v154, v50, v51
    v_cvt_pk_bf16_f32 v155, v52, v53
    v_mul_f32 v54, v54, v14
    v_mul_f32 v55, v55, v14
    v_mul_f32 v56, v56, v14
    v_mul_f32 v57, v57, v14
    v_cvt_pk_bf16_f32 v156, v54, v55
    v_cvt_pk_bf16_f32 v157, v56, v57
    v_mul_f32 v58, v58, v14
    v_mul_f32 v59, v59, v14
    v_mul_f32 v60, v60, v14
    v_mul_f32 v61, v61, v14
    v_cvt_pk_bf16_f32 v158, v58, v59
    v_cvt_pk_bf16_f32 v159, v60, v61
    ds_write_b64 v2, v[160:161] offset:48
    v_mov_b32 v12, v78
    v_mov_b32 v13, v78
    s_nop 1
    v_permlane32_swap_b32 v12, v13
    v_rcp_f32 v14, v13
    s_nop 0
    v_mul_f32 v78, v78, v14
    v_mul_f32 v79, v79, v14
    v_mul_f32 v80, v80, v14
    v_mul_f32 v81, v81, v14
    v_cvt_pk_bf16_f32 v168, v78, v79
    v_cvt_pk_bf16_f32 v169, v80, v81
    v_mul_f32 v66, v66, v14
    v_mul_f32 v67, v67, v14
    v_mul_f32 v68, v68, v14
    v_mul_f32 v69, v69, v14
    v_cvt_pk_bf16_f32 v162, v66, v67
    v_cvt_pk_bf16_f32 v163, v68, v69
    v_mul_f32 v70, v70, v14
    v_mul_f32 v71, v71, v14
    v_mul_f32 v72, v72, v14
    v_mul_f32 v73, v73, v14
    v_cvt_pk_bf16_f32 v164, v70, v71
    v_cvt_pk_bf16_f32 v165, v72, v73
    v_mul_f32 v74, v74, v14
    v_mul_f32 v75, v75, v14
    v_mul_f32 v76, v76, v14
    v_mul_f32 v77, v77, v14
    v_cvt_pk_bf16_f32 v166, v74, v75
    v_cvt_pk_bf16_f32 v167, v76, v77
    ds_write_b64 v2, v[168:169] offset:1840
    ds_write_b64 v2, v[154:155] offset:0
    ds_write_b64 v2, v[156:157] offset:16
    ds_write_b64 v2, v[158:159] offset:32
    ds_write_b64 v2, v[162:163] offset:1792
    ds_write_b64 v2, v[164:165] offset:1808
    ds_write_b64 v2, v[166:167] offset:1824
    s_waitcnt lgkmcnt(0)
    ds_read_b128 v[82:85], v4 offset:0
    ds_read_b128 v[86:89], v4 offset:1024
    ds_read_b128 v[90:93], v4 offset:2048
    ds_read_b128 v[94:97], v4 offset:3072
    s_waitcnt lgkmcnt(3)
    buffer_store_dwordx4 v[82:85], v5, s[28:31], s39 offen sc1
    s_waitcnt lgkmcnt(2)
    buffer_store_dwordx4 v[86:89], v5, s[28:31], s39 offen offset:1024 sc1
    s_waitcnt lgkmcnt(1)
    buffer_store_dwordx4 v[90:93], v5, s[28:31], s39 offen offset:2048 sc1
    s_waitcnt lgkmcnt(0)
    s_mov_b32 exec_hi, 0
    buffer_store_dwordx4 v[94:97], v5, s[28:31], s39 offen offset:3072 sc1
    s_endpgm
L_slow:
    buffer_load_dwordx4 v[106:109], v7, s[16:19], s39 offen offset:1792
    buffer_load_dwordx3 v[110:112], v7, s[16:19], s39 offen offset:1808
    s_waitcnt vmcnt(0) lgkmcnt(0)
    v_mov_b32 v16, s38
    v_mul_f32 v16, 0x3fb8aa3b, v16
    v_mov_b32 v25, 0
    v_mov_b32 v33, 0
    v_dot2_f32_bf16 v12, v98, v98, 0
    v_dot2_f32_bf16 v13, v99, v99, 0
    v_dot2_f32_bf16 v12, v100, v100, v12
    v_dot2_f32_bf16 v13, v101, v101, v13
    v_dot2_f32_bf16 v12, v102, v102, v12
    v_dot2_f32_bf16 v13, v103, v103, v13
    v_dot2_f32_bf16 v12, v104, v104, v12
    v_lshlrev_b32 v154, 16, v98
    v_and_b32 v155, 0xffff0000, v98
    v_lshlrev_b32 v156, 16, v99
    v_and_b32 v157, 0xffff0000, v99
    v_lshlrev_b32 v158, 16, v100
    v_and_b32 v159, 0xffff0000, v100
    v_lshlrev_b32 v160, 16, v101
    v_and_b32 v161, 0xffff0000, v101
    v_lshlrev_b32 v162, 16, v102
    v_and_b32 v163, 0xffff0000, v102
    v_lshlrev_b32 v164, 16, v103
    v_and_b32 v165, 0xffff0000, v103
    v_lshlrev_b32 v166, 16, v104
    v_and_b32 v167, 0xffff0000, v104
    v_add_f32 v12, v12, v13
    v_mov_b32 v13, v12
    s_nop 1
    v_permlane32_swap_b32 v12, v13
    v_add_f32 v12, v12, v13
    v_sqrt_f32 v12, v12
    s_nop 0
    v_add_f32 v12, 0x358637bd, v12
    v_rcp_f32 v14, v12
    s_nop 0
    v_pk_mul_f32 v[154:155], v[154:155], v[14:15] op_sel_hi:[1,0]
    v_cvt_pk_f16_f32 v18, v154, v155
    v_pk_mul_f32 v[156:157], v[156:157], v[14:15] op_sel_hi:[1,0]
    v_cvt_pk_f16_f32 v19, v156, v157
    v_pk_mul_f32 v[158:159], v[158:159], v[14:15] op_sel_hi:[1,0]
    v_cvt_pk_f16_f32 v20, v158, v159
    v_pk_mul_f32 v[160:161], v[160:161], v[14:15] op_sel_hi:[1,0]
    v_cvt_pk_f16_f32 v21, v160, v161
    v_pk_mul_f32 v[162:163], v[162:163], v[14:15] op_sel_hi:[1,0]
    v_cvt_pk_f16_f32 v22, v162, v163
    v_pk_mul_f32 v[164:165], v[164:165], v[14:15] op_sel_hi:[1,0]
    v_cvt_pk_f16_f32 v23, v164, v165
    v_pk_mul_f32 v[166:167], v[166:167], v[14:15] op_sel_hi:[1,0]
    v_cvt_pk_f16_f32 v24, v166, v167
    v_dot2_f32_bf16 v12, v106, v106, 0
    v_dot2_f32_bf16 v13, v107, v107, 0
    v_dot2_f32_bf16 v12, v108, v108, v12
    v_dot2_f32_bf16 v13, v109, v109, v13
    v_dot2_f32_bf16 v12, v110, v110, v12
    v_dot2_f32_bf16 v13, v111, v111, v13
    v_dot2_f32_bf16 v12, v112, v112, v12
    v_lshlrev_b32 v154, 16, v106
    v_and_b32 v155, 0xffff0000, v106
    v_lshlrev_b32 v156, 16, v107
    v_and_b32 v157, 0xffff0000, v107
    v_lshlrev_b32 v158, 16, v108
    v_and_b32 v159, 0xffff0000, v108
    v_lshlrev_b32 v160, 16, v109
    v_and_b32 v161, 0xffff0000, v109
    v_lshlrev_b32 v162, 16, v110
    v_and_b32 v163, 0xffff0000, v110
    v_lshlrev_b32 v164, 16, v111
    v_and_b32 v165, 0xffff0000, v111
    v_lshlrev_b32 v166, 16, v112
    v_and_b32 v167, 0xffff0000, v112
    v_add_f32 v12, v12, v13
    v_mov_b32 v13, v12
    s_nop 1
    v_permlane32_swap_b32 v12, v13
    v_add_f32 v12, v12, v13
    v_sqrt_f32 v12, v12
    s_nop 0
    v_add_f32 v12, 0x358637bd, v12
    v_rcp_f32 v14, v12
    s_nop 0
    v_pk_mul_f32 v[154:155], v[154:155], v[14:15] op_sel_hi:[1,0]
    v_cvt_pk_f16_f32 v26, v154, v155
    v_pk_mul_f32 v[156:157], v[156:157], v[14:15] op_sel_hi:[1,0]
    v_cvt_pk_f16_f32 v27, v156, v157
    v_pk_mul_f32 v[158:159], v[158:159], v[14:15] op_sel_hi:[1,0]
    v_cvt_pk_f16_f32 v28, v158, v159
    v_pk_mul_f32 v[160:161], v[160:161], v[14:15] op_sel_hi:[1,0]
    v_cvt_pk_f16_f32 v29, v160, v161
    v_pk_mul_f32 v[162:163], v[162:163], v[14:15] op_sel_hi:[1,0]
    v_cvt_pk_f16_f32 v30, v162, v163
    v_pk_mul_f32 v[164:165], v[164:165], v[14:15] op_sel_hi:[1,0]
    v_cvt_pk_f16_f32 v31, v164, v165
    v_pk_mul_f32 v[166:167], v[166:167], v[14:15] op_sel_hi:[1,0]
    v_cvt_pk_f16_f32 v32, v166, v167
    v_mov_b32 v50, 0
    v_mov_b32 v51, 0
    v_mov_b32 v52, 0
    v_mov_b32 v53, 0
    v_mov_b32 v54, 0
    v_mov_b32 v55, 0
    v_mov_b32 v56, 0
    v_mov_b32 v57, 0
    v_mov_b32 v58, 0
    v_mov_b32 v59, 0
    v_mov_b32 v60, 0
    v_mov_b32 v61, 0
    v_mov_b32 v62, 0
    v_mov_b32 v63, 0
    v_mov_b32 v64, 0
    v_mov_b32 v65, 0
    v_mov_b32 v66, 0
    v_mov_b32 v67, 0
    v_mov_b32 v68, 0
    v_mov_b32 v69, 0
    v_mov_b32 v70, 0
    v_mov_b32 v71, 0
    v_mov_b32 v72, 0
    v_mov_b32 v73, 0
    v_mov_b32 v74, 0
    v_mov_b32 v75, 0
    v_mov_b32 v76, 0
    v_mov_b32 v77, 0
    v_mov_b32 v78, 0
    v_mov_b32 v79, 0
    v_mov_b32 v80, 0
    v_mov_b32 v81, 0
    v_mov_b32 v130, 0xff800000
    v_mov_b32 v131, 0xff800000
    s_mov_b32 s35, 8
    s_waitcnt vmcnt(0) lgkmcnt(0)
    s_nop 15
L_slow_chunk:
    s_barrier
    buffer_load_dwordx4 v[146:149], v7, s[20:23], s34 offen
    buffer_load_dwordx3 v[150:152], v7, s[20:23], s34 offen offset:16
    s_mov_b32 m0, s49
    s_nop 0
    buffer_load_dwordx4 v5, s[24:27], s34 offen lds
    s_add_u32 m0, s49, 384
    s_nop 0
    buffer_load_dwordx4 v5, s[24:27], s34 offen offset:896 lds
    s_add_u32 s34, s34, 14336
    s_waitcnt vmcnt(0) lgkmcnt(0)
    v_dot2_f32_bf16 v12, v146, v146, 0
    v_dot2_f32_bf16 v13, v147, v147, 0
    v_dot2_f32_bf16 v12, v148, v148, v12
    v_dot2_f32_bf16 v13, v149, v149, v13
    v_dot2_f32_bf16 v12, v150, v150, v12
    v_dot2_f32_bf16 v13, v151, v151, v13
    v_dot2_f32_bf16 v12, v152, v152, v12
    v_lshlrev_b32 v154, 16, v146
    v_and_b32 v155, 0xffff0000, v146
    v_lshlrev_b32 v156, 16, v147
    v_and_b32 v157, 0xffff0000, v147
    v_lshlrev_b32 v158, 16, v148
    v_and_b32 v159, 0xffff0000, v148
    v_lshlrev_b32 v160, 16, v149
    v_and_b32 v161, 0xffff0000, v149
    v_lshlrev_b32 v162, 16, v150
    v_and_b32 v163, 0xffff0000, v150
    v_lshlrev_b32 v164, 16, v151
    v_and_b32 v165, 0xffff0000, v151
    v_lshlrev_b32 v166, 16, v152
    v_and_b32 v167, 0xffff0000, v152
    v_add_f32 v12, v12, v13
    v_mov_b32 v13, v12
    s_nop 1
    v_permlane32_swap_b32 v12, v13
    v_add_f32 v12, v12, v13
    v_sqrt_f32 v12, v12
    s_nop 0
    v_add_f32 v12, 0x358637bd, v12
    v_rcp_f32 v14, v12
    s_nop 0
    v_pk_mul_f32 v[154:155], v[154:155], v[14:15] op_sel_hi:[1,0]
    v_cvt_pk_f16_f32 v168, v154, v155
    v_pk_mul_f32 v[156:157], v[156:157], v[14:15] op_sel_hi:[1,0]
    v_cvt_pk_f16_f32 v169, v156, v157
    v_pk_mul_f32 v[158:159], v[158:159], v[14:15] op_sel_hi:[1,0]
    v_cvt_pk_f16_f32 v170, v158, v159
    v_pk_mul_f32 v[160:161], v[160:161], v[14:15] op_sel_hi:[1,0]
    v_cvt_pk_f16_f32 v171, v160, v161
    v_pk_mul_f32 v[162:163], v[162:163], v[14:15] op_sel_hi:[1,0]
    v_cvt_pk_f16_f32 v172, v162, v163
    v_pk_mul_f32 v[164:165], v[164:165], v[14:15] op_sel_hi:[1,0]
    v_cvt_pk_f16_f32 v173, v164, v165
    v_pk_mul_f32 v[166:167], v[166:167], v[14:15] op_sel_hi:[1,0]
    v_cvt_pk_f16_f32 v174, v166, v167
    ds_write_b128 v6, v[168:171] offset:0
    ds_write_b128 v6, v[172:175] offset:1024
    s_waitcnt lgkmcnt(0)
    s_barrier
    v_mov_b32 v4, v2
    v_mov_b32 v8, v3
    s_mov_b32 s36, 8
    s_nop 15
L_slow_tile:
    ds_read_b128 v[34:37], v4 offset:0
    ds_read_b128 v[38:41], v4 offset:1024
    ds_read_b64_tr_b16 v[42:43], v8 offset:16384
    ds_read_b64_tr_b16 v[44:45], v8 offset:16608
    ds_read_b64_tr_b16 v[46:47], v8 offset:17664
    ds_read_b64_tr_b16 v[48:49], v8 offset:17888
    v_add_u32 v4, 2048, v4
    v_add_u32 v8, 2560, v8
    s_waitcnt lgkmcnt(5)
    v_mfma_f32_32x32x16_f16 v[82:97], v[34:37], v[18:21], 0
    s_waitcnt lgkmcnt(4)
    v_mfma_f32_32x32x16_f16 v[82:97], v[38:41], v[22:25], v[82:97]
    v_mfma_f32_32x32x16_f16 v[114:129], v[34:37], v[26:29], 0
    v_mfma_f32_32x32x16_f16 v[114:129], v[38:41], v[30:33], v[114:129]
    s_nop 9
    v_mul_f32 v82, v82, v16
    v_mul_f32 v83, v83, v16
    v_mul_f32 v84, v84, v16
    v_mul_f32 v85, v85, v16
    v_mul_f32 v86, v86, v16
    v_mul_f32 v87, v87, v16
    v_mul_f32 v88, v88, v16
    v_mul_f32 v89, v89, v16
    v_mul_f32 v90, v90, v16
    v_mul_f32 v91, v91, v16
    v_mul_f32 v92, v92, v16
    v_mul_f32 v93, v93, v16
    v_mul_f32 v94, v94, v16
    v_mul_f32 v95, v95, v16
    v_mul_f32 v96, v96, v16
    v_mul_f32 v97, v97, v16
    v_max3_f32 v133, v82, v83, v84
    v_max3_f32 v133, v133, v85, v86
    v_max3_f32 v133, v133, v87, v88
    v_max3_f32 v133, v133, v89, v90
    v_max3_f32 v133, v133, v91, v92
    v_max3_f32 v133, v133, v93, v94
    v_max3_f32 v133, v133, v95, v96
    v_max_f32 v133, v133, v97
    v_mov_b32 v134, v133
    s_nop 1
    v_permlane32_swap_b32 v133, v134
    v_max3_f32 v133, v133, v134, v130
    v_sub_f32 v132, v130, v133
    v_exp_f32 v132, v132
    v_mov_b32 v130, v133
    v_mul_f32 v50, v50, v132
    v_mul_f32 v51, v51, v132
    v_mul_f32 v52, v52, v132
    v_mul_f32 v53, v53, v132
    v_mul_f32 v54, v54, v132
    v_mul_f32 v55, v55, v132
    v_mul_f32 v56, v56, v132
    v_mul_f32 v57, v57, v132
    v_mul_f32 v58, v58, v132
    v_mul_f32 v59, v59, v132
    v_mul_f32 v60, v60, v132
    v_mul_f32 v61, v61, v132
    v_mul_f32 v62, v62, v132
    v_mul_f32 v63, v63, v132
    v_mul_f32 v64, v64, v132
    v_mul_f32 v65, v65, v132
    v_sub_f32 v82, v82, v130
    v_sub_f32 v83, v83, v130
    v_sub_f32 v84, v84, v130
    v_sub_f32 v85, v85, v130
    v_sub_f32 v86, v86, v130
    v_sub_f32 v87, v87, v130
    v_sub_f32 v88, v88, v130
    v_sub_f32 v89, v89, v130
    v_sub_f32 v90, v90, v130
    v_sub_f32 v91, v91, v130
    v_sub_f32 v92, v92, v130
    v_sub_f32 v93, v93, v130
    v_sub_f32 v94, v94, v130
    v_sub_f32 v95, v95, v130
    v_sub_f32 v96, v96, v130
    v_sub_f32 v97, v97, v130
    v_exp_f32 v82, v82
    v_exp_f32 v83, v83
    v_exp_f32 v84, v84
    v_exp_f32 v85, v85
    v_exp_f32 v86, v86
    v_exp_f32 v87, v87
    v_exp_f32 v88, v88
    v_exp_f32 v89, v89
    v_exp_f32 v90, v90
    v_exp_f32 v91, v91
    v_exp_f32 v92, v92
    v_exp_f32 v93, v93
    v_exp_f32 v94, v94
    v_exp_f32 v95, v95
    v_exp_f32 v96, v96
    v_exp_f32 v97, v97
    s_waitcnt lgkmcnt(2)
    v_smfmac_f32_32x32x32_bf16 v[50:65], v[42:45], v[82:89], v9
    s_waitcnt lgkmcnt(0)
    v_smfmac_f32_32x32x32_bf16 v[50:65], v[46:49], v[90:97], v9
    v_mul_f32 v114, v114, v16
    v_mul_f32 v115, v115, v16
    v_mul_f32 v116, v116, v16
    v_mul_f32 v117, v117, v16
    v_mul_f32 v118, v118, v16
    v_mul_f32 v119, v119, v16
    v_mul_f32 v120, v120, v16
    v_mul_f32 v121, v121, v16
    v_mul_f32 v122, v122, v16
    v_mul_f32 v123, v123, v16
    v_mul_f32 v124, v124, v16
    v_mul_f32 v125, v125, v16
    v_mul_f32 v126, v126, v16
    v_mul_f32 v127, v127, v16
    v_mul_f32 v128, v128, v16
    v_mul_f32 v129, v129, v16
    v_max3_f32 v133, v114, v115, v116
    v_max3_f32 v133, v133, v117, v118
    v_max3_f32 v133, v133, v119, v120
    v_max3_f32 v133, v133, v121, v122
    v_max3_f32 v133, v133, v123, v124
    v_max3_f32 v133, v133, v125, v126
    v_max3_f32 v133, v133, v127, v128
    v_max_f32 v133, v133, v129
    v_mov_b32 v134, v133
    s_nop 1
    v_permlane32_swap_b32 v133, v134
    v_max3_f32 v133, v133, v134, v131
    v_sub_f32 v132, v131, v133
    v_exp_f32 v132, v132
    v_mov_b32 v131, v133
    v_mul_f32 v66, v66, v132
    v_mul_f32 v67, v67, v132
    v_mul_f32 v68, v68, v132
    v_mul_f32 v69, v69, v132
    v_mul_f32 v70, v70, v132
    v_mul_f32 v71, v71, v132
    v_mul_f32 v72, v72, v132
    v_mul_f32 v73, v73, v132
    v_mul_f32 v74, v74, v132
    v_mul_f32 v75, v75, v132
    v_mul_f32 v76, v76, v132
    v_mul_f32 v77, v77, v132
    v_mul_f32 v78, v78, v132
    v_mul_f32 v79, v79, v132
    v_mul_f32 v80, v80, v132
    v_mul_f32 v81, v81, v132
    v_sub_f32 v114, v114, v131
    v_sub_f32 v115, v115, v131
    v_sub_f32 v116, v116, v131
    v_sub_f32 v117, v117, v131
    v_sub_f32 v118, v118, v131
    v_sub_f32 v119, v119, v131
    v_sub_f32 v120, v120, v131
    v_sub_f32 v121, v121, v131
    v_sub_f32 v122, v122, v131
    v_sub_f32 v123, v123, v131
    v_sub_f32 v124, v124, v131
    v_sub_f32 v125, v125, v131
    v_sub_f32 v126, v126, v131
    v_sub_f32 v127, v127, v131
    v_sub_f32 v128, v128, v131
    v_sub_f32 v129, v129, v131
    v_exp_f32 v114, v114
    v_exp_f32 v115, v115
    v_exp_f32 v116, v116
    v_exp_f32 v117, v117
    v_exp_f32 v118, v118
    v_exp_f32 v119, v119
    v_exp_f32 v120, v120
    v_exp_f32 v121, v121
    v_exp_f32 v122, v122
    v_exp_f32 v123, v123
    v_exp_f32 v124, v124
    v_exp_f32 v125, v125
    v_exp_f32 v126, v126
    v_exp_f32 v127, v127
    v_exp_f32 v128, v128
    v_exp_f32 v129, v129
    v_smfmac_f32_32x32x32_bf16 v[66:81], v[42:45], v[114:121], v9
    s_nop 0
    v_smfmac_f32_32x32x32_bf16 v[66:81], v[46:49], v[122:129], v9
    s_nop 15
    s_sub_u32 s36, s36, 1
    s_cmp_lg_u32 s36, 0
    s_cbranch_scc1 L_slow_tile
    s_sub_u32 s35, s35, 1
    s_cmp_lg_u32 s35, 0
    s_cbranch_scc1 L_slow_chunk
    s_lshl_b32 s50, s33, 12
    s_add_u32 s50, s50, 73728
    v_add_u32 v2, s50, v17
    v_add_u32 v4, s50, v5
    v_mov_b32 v12, v62
    v_mov_b32 v13, v62
    s_nop 1
    v_permlane32_swap_b32 v12, v13
    v_rcp_f32 v14, v13
    s_nop 0
    v_mul_f32 v62, v62, v14
    v_mul_f32 v63, v63, v14
    v_mul_f32 v64, v64, v14
    v_mul_f32 v65, v65, v14
    v_cvt_pk_bf16_f32 v160, v62, v63
    v_cvt_pk_bf16_f32 v161, v64, v65
    v_mul_f32 v50, v50, v14
    v_mul_f32 v51, v51, v14
    v_mul_f32 v52, v52, v14
    v_mul_f32 v53, v53, v14
    v_cvt_pk_bf16_f32 v154, v50, v51
    v_cvt_pk_bf16_f32 v155, v52, v53
    v_mul_f32 v54, v54, v14
    v_mul_f32 v55, v55, v14
    v_mul_f32 v56, v56, v14
    v_mul_f32 v57, v57, v14
    v_cvt_pk_bf16_f32 v156, v54, v55
    v_cvt_pk_bf16_f32 v157, v56, v57
    v_mul_f32 v58, v58, v14
    v_mul_f32 v59, v59, v14
    v_mul_f32 v60, v60, v14
    v_mul_f32 v61, v61, v14
    v_cvt_pk_bf16_f32 v158, v58, v59
    v_cvt_pk_bf16_f32 v159, v60, v61
    ds_write_b64 v2, v[160:161] offset:48
    v_mov_b32 v12, v78
    v_mov_b32 v13, v78
    s_nop 1
    v_permlane32_swap_b32 v12, v13
    v_rcp_f32 v14, v13
    s_nop 0
    v_mul_f32 v78, v78, v14
    v_mul_f32 v79, v79, v14
    v_mul_f32 v80, v80, v14
    v_mul_f32 v81, v81, v14
    v_cvt_pk_bf16_f32 v168, v78, v79
    v_cvt_pk_bf16_f32 v169, v80, v81
    v_mul_f32 v66, v66, v14
    v_mul_f32 v67, v67, v14
    v_mul_f32 v68, v68, v14
    v_mul_f32 v69, v69, v14
    v_cvt_pk_bf16_f32 v162, v66, v67
    v_cvt_pk_bf16_f32 v163, v68, v69
    v_mul_f32 v70, v70, v14
    v_mul_f32 v71, v71, v14
    v_mul_f32 v72, v72, v14
    v_mul_f32 v73, v73, v14
    v_cvt_pk_bf16_f32 v164, v70, v71
    v_cvt_pk_bf16_f32 v165, v72, v73
    v_mul_f32 v74, v74, v14
    v_mul_f32 v75, v75, v14
    v_mul_f32 v76, v76, v14
    v_mul_f32 v77, v77, v14
    v_cvt_pk_bf16_f32 v166, v74, v75
    v_cvt_pk_bf16_f32 v167, v76, v77
    ds_write_b64 v2, v[168:169] offset:1840
    ds_write_b64 v2, v[154:155] offset:0
    ds_write_b64 v2, v[156:157] offset:16
    ds_write_b64 v2, v[158:159] offset:32
    ds_write_b64 v2, v[162:163] offset:1792
    ds_write_b64 v2, v[164:165] offset:1808
    ds_write_b64 v2, v[166:167] offset:1824
    s_waitcnt lgkmcnt(0)
    ds_read_b128 v[82:85], v4 offset:0
    ds_read_b128 v[86:89], v4 offset:1024
    ds_read_b128 v[90:93], v4 offset:2048
    ds_read_b128 v[94:97], v4 offset:3072
    s_waitcnt lgkmcnt(3)
    buffer_store_dwordx4 v[82:85], v5, s[28:31], s39 offen sc1
    s_waitcnt lgkmcnt(2)
    buffer_store_dwordx4 v[86:89], v5, s[28:31], s39 offen offset:1024 sc1
    s_waitcnt lgkmcnt(1)
    buffer_store_dwordx4 v[90:93], v5, s[28:31], s39 offen offset:2048 sc1
    s_waitcnt lgkmcnt(0)
    s_mov_b32 exec_hi, 0
    buffer_store_dwordx4 v[94:97], v5, s[28:31], s39 offen offset:3072 sc1
    s_endpgm
L_exit:
    s_endpgm
.section .rodata,"a"
.p2align 6
.amdhsa_kernel standalone__qk_norm__prompt_kernel
  .amdhsa_next_free_vgpr 176
  .amdhsa_next_free_sgpr 56
  .amdhsa_accum_offset 176
  .amdhsa_group_segment_fixed_size 0
  .amdhsa_kernarg_size 56
  .amdhsa_user_sgpr_count 2
  .amdhsa_user_sgpr_kernarg_segment_ptr 1
  .amdhsa_system_sgpr_workgroup_id_x 1
.end_amdhsa_kernel
```
